```python
import torch

def _softmax(x, axis=-1):
    return torch.softmax(x, dim=axis)
def _gelu(x):
    return torch.nn.functional.gelu(x, approximate="tanh")
def _silu(x):
    return torch.nn.functional.silu(x)
def _sigmoid(x):
    return torch.sigmoid(x)
def _layernorm(x, axis=-1, eps=1e-5):
    m = x.mean(dim=axis, keepdim=True)
    v = x.var(dim=axis, keepdim=True, unbiased=False)
    return (x - m) / torch.sqrt(v + eps)
def _scatter_add(tgt, idx, src, axis=0):
    return tgt.clone().index_add_(axis, idx, src)
def _segment_sum(src, seg, n):
    out = torch.zeros((n,) + src.shape[1:], dtype=src.dtype)
    return out.index_add_(0, seg, src)
def _pad(x, pw):
    flat = tuple(v for pair in reversed(pw) for v in pair)
    return torch.nn.functional.pad(x, flat)

kernel_name = 'standalone__spectral_fnet__prompt'

def setup_inputs():

    _w = (lambda a: (lambda t: t.to(torch.bfloat16) if t.is_floating_point() else t)(torch.as_tensor(a)))
    B, S, D = 1, 2048, 1024
    ns = torch.arange(S)[:, None] * torch.arange(S)[None, :]
    nd = torch.arange(D)[:, None] * torch.arange(D)[None, :]
    Ws_re = torch.cos(-2.0 * torch.pi * ns / S).to(float)
    Ws_im = torch.sin(-2.0 * torch.pi * ns / S).to(float)
    Wd_re = torch.cos(-2.0 * torch.pi * nd / D).to(float)
    Wd_im = torch.sin(-2.0 * torch.pi * nd / D).to(float)
    return {
        "x": _w((lambda *s: torch.randn(*s, dtype=torch.bfloat16) * 0.05)(B, S, D)),
        "dft_seq_re": _w(Ws_re),
        "dft_seq_im": _w(Ws_im),
        "dft_hid_re": _w(Wd_re),
        "dft_hid_im": _w(Wd_im),
    }

def reference(x, dft_seq_re, dft_seq_im, dft_hid_re, dft_hid_im):
    a = torch.einsum("bsd,ed->bse", x, dft_hid_re)
    b = torch.einsum("bsd,ed->bse", x, dft_hid_im)
    y = torch.einsum("ts,bse->bte", dft_seq_re, a) - torch.einsum("ts,bse->bte", dft_seq_im, b)
    return y
```

```asm
; @launch grid=(256,1,1) block=(512,1,1) lds=131072
.amdgcn_target "amdgcn-amd-amdhsa--gfx950"
.text
.globl standalone__spectral_fnet__prompt_kernel
.p2align 8
.type standalone__spectral_fnet__prompt_kernel,@function
standalone__spectral_fnet__prompt_kernel:
  s_cmp_ge_u32 s2, 256
  s_cbranch_scc1 L_done
  s_load_dwordx16 s[32:47], s[0:1], 0
  v_lshrrev_b32 v1, 6, v0
  v_and_b32 v2, 63, v0
  v_readfirstlane_b32 s20, v1
  s_and_b32 s3, s2, 1
  s_bfe_u32 s49, s2, 0x20001
  s_bfe_u32 s48, s2, 0x20003
  s_lshr_b32 s28, s2, 5
  s_lshl_b32 s27, s49, 2
  s_add_u32 s27, s27, s48
  s_cmp_lt_u32 s20, 4
  s_cbranch_scc1 L_compute
  s_sub_u32 s20, s20, 4
  v_lshrrev_b32 v3, 3, v2
  v_and_b32 v4, 7, v2
  v_lshrrev_b32 v5, 4, v2
  v_xor_b32 v4, v4, v5
  v_lshlrev_b32 v4, 4, v4
  s_lshl_b32 s50, s20, 5
  v_add_u32 v3, s50, v3
  v_lshlrev_b32 v8, 11, v3
  v_add_u32 v8, v8, v4
  v_xor_b32 v9, 64, v8
  v_add_u32 v10, 30720, v8
  v_add_u32 v11, 46080, v9
  v_add_u32 v9, 15360, v9
  v_mov_b32 v12, v8
  v_mov_b32 v13, v9
  v_mov_b32 v14, v10
  v_mov_b32 v15, v11
  s_lshl_b32 s54, s20, 12
  s_add_u32 s56, s48, s28
  s_and_b32 s56, s56, 3
  v_and_b32 v5, 3, v2
  v_cmp_eq_u32 vcc, s56, v5
  v_add_u32 v6, 4, v2
  s_nop 0
  v_cndmask_b32 v28, v2, v6, vcc
  v_and_b32 v28, 15, v28
  v_lshlrev_b32 v28, 7, v28
  s_lshl_b32 s70, s27, 18
  s_mov_b32 s57, 0
  s_lshl_b32 s71, s28, 18
  s_mov_b32 s58, 0
  s_mov_b32 s52, 0
  s_mov_b32 s6, 0x400000
  s_mov_b32 s7, 0x20000
  s_mov_b32 s10, 0x200000
  s_mov_b32 s11, 0x20000
  v_readlane_b32 s59, v28, s58
  s_add_u32 s62, s52, s54
  s_mov_b32 m0, s62
  s_add_u32 s58, s58, 1
  s_add_u32 s52, s52, 32768
  s_and_b32 s52, s52, 131071
  s_lshl_b32 s53, s59, s57
  s_add_u32 s53, s53, s70
  s_add_u32 s55, s59, s71
  s_waitcnt lgkmcnt(0)
  s_mov_b32 s4, s32
  s_mov_b32 s5, s33
  s_cmp_eq_u32 s3, 0
  s_cselect_b32 s8, s38, s40
  s_cselect_b32 s9, s39, s41
  buffer_load_dwordx4 v8, s[4:7], s53 offen offset:0 sc1 lds
  buffer_load_dwordx4 v9, s[4:7], s53 offen offset:1024 sc1 lds
  buffer_load_dwordx4 v10, s[4:7], s53 offen offset:2048 sc1 lds
  buffer_load_dwordx4 v11, s[4:7], s53 offen offset:3072 sc1 lds
  s_add_u32 m0, s62, 16384
  s_nop 0
  buffer_load_dwordx4 v12, s[8:11], s55 offen offset:0 lds
  buffer_load_dwordx4 v13, s[8:11], s55 offen offset:1024 lds
  buffer_load_dwordx4 v14, s[8:11], s55 offen offset:2048 lds
  buffer_load_dwordx4 v15, s[8:11], s55 offen offset:3072 lds
  v_readlane_b32 s59, v28, s58
  s_add_u32 s62, s52, s54
  s_mov_b32 m0, s62
  s_add_u32 s58, s58, 1
  s_add_u32 s52, s52, 32768
  s_and_b32 s52, s52, 131071
  s_lshl_b32 s53, s59, s57
  s_add_u32 s53, s53, s70
  s_add_u32 s55, s59, s71
  buffer_load_dwordx4 v8, s[4:7], s53 offen offset:0 sc1 lds
  buffer_load_dwordx4 v9, s[4:7], s53 offen offset:1024 sc1 lds
  buffer_load_dwordx4 v10, s[4:7], s53 offen offset:2048 sc1 lds
  buffer_load_dwordx4 v11, s[4:7], s53 offen offset:3072 sc1 lds
  s_add_u32 m0, s62, 16384
  s_nop 0
  buffer_load_dwordx4 v12, s[8:11], s55 offen offset:0 lds
  buffer_load_dwordx4 v13, s[8:11], s55 offen offset:1024 lds
  buffer_load_dwordx4 v14, s[8:11], s55 offen offset:2048 lds
  buffer_load_dwordx4 v15, s[8:11], s55 offen offset:3072 lds
  v_readlane_b32 s59, v28, s58
  s_add_u32 s62, s52, s54
  s_mov_b32 m0, s62
  s_add_u32 s58, s58, 1
  s_add_u32 s52, s52, 32768
  s_and_b32 s52, s52, 131071
  s_lshl_b32 s53, s59, s57
  s_add_u32 s53, s53, s70
  s_add_u32 s55, s59, s71
  s_add_u32 s92, s46, 0xC00000
  s_addc_u32 s93, s47, 0
  s_mov_b32 s94, 0x10000
  s_mov_b32 s95, 0x20000
  s_mov_b32 s12, s44
  s_mov_b32 s13, s45
  s_mov_b32 s14, 256
  s_mov_b32 s15, 0x20000
  v_mov_b32 v31, 0
  s_or_b32 s60, s2, s20
  s_cmp_eq_u32 s60, 0
  s_cbranch_scc0 L_nononce
  s_memrealtime s[64:65]
  s_waitcnt lgkmcnt(0)
  s_or_b32 s64, s64, 1
  v_mov_b32 v25, s64
  s_mov_b64 exec, 1
  buffer_store_dword v25, v31, s[12:15], 0 offen sc1
  s_mov_b64 exec, -1
L_nononce:
  v_lshlrev_b32 v16, 4, v2
  v_add_u32 v16, s54, v16
  v_mov_b32 v17, v16
  v_mov_b32 v18, v16
  v_mov_b32 v19, v16
  v_lshlrev_b32 v20, 12, v3
  v_add_u32 v20, v20, v4
  v_xor_b32 v21, 64, v20
  v_add_u32 v22, 63488, v20
  v_add_u32 v23, 95232, v21
  v_add_u32 v21, 31744, v21
  v_subrev_u32 v5, 2, v2
  v_and_b32 v6, 3, v5
  v_cmp_eq_u32 vcc, s56, v6
  v_add_u32 v6, 4, v5
  s_cmp_lt_u32 s56, 2
  s_cselect_b32 s64, 32, 28
  v_cndmask_b32 v5, v5, v6, vcc
  v_subrev_u32 v6, s64, v5
  v_cmp_le_u32 vcc, 30, v5
  s_lshl_b32 s60, s48, 1
  s_add_u32 s64, s60, 2
  v_cndmask_b32 v5, v5, v6, vcc
  v_add_u32 v6, s64, v5
  v_and_b32 v6, 7, v6
  v_cmp_le_u32 vcc, 24, v5
  v_add_u32 v5, 8, v5
  v_add_u32 v7, s60, v2
  v_cndmask_b32 v5, v5, v6, vcc
  v_cmp_gt_u32 vcc, 2, v2
  s_lshl_b32 s60, s49, 3
  s_nop 0
  v_cndmask_b32 v5, v5, v7, vcc
  v_add_u32 v5, s60, v5
  v_and_b32 v5, 31, v5
  v_lshlrev_b32 v29, 7, v5
  s_lshl_b32 s60, s3, 3
  s_add_u32 s60, s60, s28
  s_lshl_b32 s60, s60, 4
  v_add_u32 v24, s60, v2
  s_xor_b32 s64, s60, 128
  s_add_u32 s64, s64, s27
  v_mov_b32 v26, s64
  v_cmp_ne_u32 vcc, s27, v2
  s_add_u32 s60, s60, s27
  s_lshl_b32 s60, s60, 8
  v_cndmask_b32 v24, v26, v24, vcc
  v_lshlrev_b32 v24, 8, v24
  v_lshlrev_b32 v27, 2, v2
  v_add_u32 v27, s60, v27
  s_mov_b32 s63, 0
  s_mov_b32 s61, 14
L_lloop:
  s_waitcnt vmcnt(8)
  s_barrier
  buffer_load_dwordx4 v8, s[4:7], s53 offen offset:0 sc1 lds
  buffer_load_dwordx4 v9, s[4:7], s53 offen offset:1024 sc1 lds
  buffer_load_dwordx4 v10, s[4:7], s53 offen offset:2048 sc1 lds
  buffer_load_dwordx4 v11, s[4:7], s53 offen offset:3072 sc1 lds
  s_add_u32 m0, s62, 16384
  s_nop 0
  buffer_load_dwordx4 v12, s[8:11], s55 offen offset:0 lds
  buffer_load_dwordx4 v13, s[8:11], s55 offen offset:1024 lds
  buffer_load_dwordx4 v14, s[8:11], s55 offen offset:2048 lds
  buffer_load_dwordx4 v15, s[8:11], s55 offen offset:3072 lds
  s_add_u32 s63, s63, 1
  s_cmp_eq_u32 s63, s61
  s_cbranch_scc1 L_lexit
  v_readlane_b32 s59, v28, s58
  s_add_u32 s62, s52, s54
  s_mov_b32 m0, s62
  s_add_u32 s58, s58, 1
  s_add_u32 s52, s52, 32768
  s_and_b32 s52, s52, 131071
  s_lshl_b32 s53, s59, s57
  s_add_u32 s53, s53, s70
  s_add_u32 s55, s59, s71
  s_branch L_lloop
L_lexit:
  s_cmp_eq_u32 s61, 14
  s_cbranch_scc0 L_lend
  buffer_load_dword v25, v31, s[12:15], 0 offen sc1
  s_mov_b32 s4, s46
  s_mov_b32 s5, s47
  s_mov_b32 s6, 0x800000
  s_cmp_eq_u32 s3, 0
  s_cselect_b32 s8, s34, s36
  s_cselect_b32 s9, s35, s37
  s_mov_b32 s10, 0x800000
  v_mov_b32 v8, v16
  v_mov_b32 v9, v17
  v_mov_b32 v10, v18
  v_mov_b32 v11, v19
  v_mov_b32 v12, v20
  v_mov_b32 v13, v21
  v_mov_b32 v14, v22
  v_mov_b32 v15, v23
  v_mov_b32 v28, v29
  s_lshl_b32 s70, s3, 3
  s_add_u32 s70, s70, s28
  s_lshl_b32 s70, s70, 19
  s_mov_b32 s57, 7
  s_lshl_b32 s71, s27, 19
  s_mov_b32 s58, 0
  v_readlane_b32 s59, v28, s58
  s_add_u32 s62, s52, s54
  s_mov_b32 m0, s62
  s_add_u32 s58, s58, 1
  s_add_u32 s52, s52, 32768
  s_and_b32 s52, s52, 131071
  s_lshl_b32 s53, s59, s57
  s_add_u32 s53, s53, s70
  s_add_u32 s55, s59, s71
  s_add_u32 m0, s62, 16384
  s_nop 0
  s_waitcnt vmcnt(8)
  s_barrier
  buffer_load_dwordx4 v12, s[8:11], s55 offen offset:0 lds
  buffer_load_dwordx4 v13, s[8:11], s55 offen offset:1024 lds
  buffer_load_dwordx4 v14, s[8:11], s55 offen offset:2048 lds
  buffer_load_dwordx4 v15, s[8:11], s55 offen offset:3072 lds
  v_readlane_b32 s59, v28, s58
  s_add_u32 s62, s52, s54
  s_mov_b32 m0, s62
  s_add_u32 s58, s58, 1
  s_add_u32 s52, s52, 32768
  s_and_b32 s52, s52, 131071
  s_lshl_b32 s53, s59, s57
  s_add_u32 s53, s53, s70
  s_add_u32 s55, s59, s71
  s_add_u32 m0, s62, 16384
  s_nop 0
  buffer_load_dwordx4 v12, s[8:11], s55 offen offset:0 lds
  buffer_load_dwordx4 v13, s[8:11], s55 offen offset:1024 lds
  buffer_load_dwordx4 v14, s[8:11], s55 offen offset:2048 lds
  buffer_load_dwordx4 v15, s[8:11], s55 offen offset:3072 lds
  v_readlane_b32 s59, v28, s58
  s_add_u32 s62, s52, s54
  s_mov_b32 m0, s62
  s_add_u32 s58, s58, 1
  s_add_u32 s52, s52, 32768
  s_and_b32 s52, s52, 131071
  s_lshl_b32 s53, s59, s57
  s_add_u32 s53, s53, s70
  s_add_u32 s55, s59, s71
  s_add_u32 m0, s62, 16384
  s_mov_b32 s72, s53
  s_mov_b32 s76, s62
  s_waitcnt vmcnt(8)
  s_barrier
  buffer_load_dwordx4 v12, s[8:11], s55 offen offset:0 lds
  buffer_load_dwordx4 v13, s[8:11], s55 offen offset:1024 lds
  buffer_load_dwordx4 v14, s[8:11], s55 offen offset:2048 lds
  buffer_load_dwordx4 v15, s[8:11], s55 offen offset:3072 lds
  s_mov_b32 s64, 0x40000
L_np:
  v_readfirstlane_b32 s60, v25
  s_cmp_lg_u32 s60, 0
  s_cbranch_scc1 L_npd
  s_sub_u32 s64, s64, 1
  s_cmp_eq_u32 s64, 0
  s_cbranch_scc1 L_npd
  buffer_load_dword v25, v31, s[12:15], 0 offen sc1
  s_waitcnt vmcnt(0)
  s_branch L_np
L_npd:
  v_readlane_b32 s59, v28, s58
  s_add_u32 s62, s52, s54
  s_mov_b32 m0, s62
  s_add_u32 s58, s58, 1
  s_add_u32 s52, s52, 32768
  s_and_b32 s52, s52, 131071
  s_lshl_b32 s53, s59, s57
  s_add_u32 s53, s53, s70
  s_add_u32 s55, s59, s71
  s_add_u32 m0, s62, 16384
  s_mov_b32 s73, s53
  s_mov_b32 s77, s62
  s_waitcnt vmcnt(4)
  s_barrier
  buffer_load_dwordx4 v12, s[8:11], s55 offen offset:0 lds
  buffer_load_dwordx4 v13, s[8:11], s55 offen offset:1024 lds
  buffer_load_dwordx4 v14, s[8:11], s55 offen offset:2048 lds
  buffer_load_dwordx4 v15, s[8:11], s55 offen offset:3072 lds
  v_readlane_b32 s59, v28, s58
  s_add_u32 s62, s52, s54
  s_mov_b32 m0, s62
  s_add_u32 s58, s58, 1
  s_add_u32 s52, s52, 32768
  s_and_b32 s52, s52, 131071
  s_lshl_b32 s53, s59, s57
  s_add_u32 s53, s53, s70
  s_add_u32 s55, s59, s71
  s_add_u32 m0, s62, 16384
  s_mov_b32 s74, s53
  s_mov_b32 s78, s62
  s_barrier
  s_barrier
  s_cmp_eq_u32 s20, 0
  s_cbranch_scc0 L_noflag
  buffer_store_dword v25, v27, s[92:95], 0 offen sc1
L_noflag:
  s_mov_b32 s64, 0x40000
  buffer_load_dwordx4 v12, s[8:11], s55 offen offset:0 lds
  buffer_load_dwordx4 v13, s[8:11], s55 offen offset:1024 lds
  buffer_load_dwordx4 v14, s[8:11], s55 offen offset:2048 lds
  buffer_load_dwordx4 v15, s[8:11], s55 offen offset:3072 lds
  v_readlane_b32 s59, v28, s58
  s_add_u32 s62, s52, s54
  s_mov_b32 m0, s62
  s_add_u32 s58, s58, 1
  s_add_u32 s52, s52, 32768
  s_and_b32 s52, s52, 131071
  s_lshl_b32 s53, s59, s57
  s_add_u32 s53, s53, s70
  s_add_u32 s55, s59, s71
  s_add_u32 m0, s62, 16384
  s_mov_b32 s75, s53
  s_mov_b32 s79, s62
  buffer_load_dwordx4 v12, s[8:11], s55 offen offset:0 lds
  buffer_load_dwordx4 v13, s[8:11], s55 offen offset:1024 lds
  buffer_load_dwordx4 v14, s[8:11], s55 offen offset:2048 lds
  buffer_load_dwordx4 v15, s[8:11], s55 offen offset:3072 lds
  s_mov_b64 exec, 0xffff
L_poll:
  buffer_load_dword v26, v24, s[92:95], 0 offen sc1
  s_waitcnt vmcnt(0)
  v_cmp_ne_u32 vcc, v26, v25
  s_sub_u32 s64, s64, 1
  s_cmp_eq_u32 s64, 0
  s_cbranch_scc1 L_pdone
  s_cbranch_vccz L_pdone
  s_sleep 1
  s_branch L_poll
L_pdone:
  s_mov_b64 exec, -1
  s_mov_b32 m0, s76
  s_nop 0
  buffer_load_dwordx4 v8, s[4:7], s72 offen offset:0 sc1 lds
  buffer_load_dwordx4 v9, s[4:7], s72 offen offset:1024 sc1 lds
  buffer_load_dwordx4 v10, s[4:7], s72 offen offset:2048 sc1 lds
  buffer_load_dwordx4 v11, s[4:7], s72 offen offset:3072 sc1 lds
  s_mov_b32 m0, s77
  s_nop 0
  buffer_load_dwordx4 v8, s[4:7], s73 offen offset:0 sc1 lds
  buffer_load_dwordx4 v9, s[4:7], s73 offen offset:1024 sc1 lds
  buffer_load_dwordx4 v10, s[4:7], s73 offen offset:2048 sc1 lds
  buffer_load_dwordx4 v11, s[4:7], s73 offen offset:3072 sc1 lds
  s_waitcnt vmcnt(4)
  s_barrier
  s_mov_b32 m0, s78
  s_nop 0
  buffer_load_dwordx4 v8, s[4:7], s74 offen offset:0 sc1 lds
  buffer_load_dwordx4 v9, s[4:7], s74 offen offset:1024 sc1 lds
  buffer_load_dwordx4 v10, s[4:7], s74 offen offset:2048 sc1 lds
  buffer_load_dwordx4 v11, s[4:7], s74 offen offset:3072 sc1 lds
  s_mov_b32 m0, s79
  s_nop 0
  buffer_load_dwordx4 v8, s[4:7], s75 offen offset:0 sc1 lds
  buffer_load_dwordx4 v9, s[4:7], s75 offen offset:1024 sc1 lds
  buffer_load_dwordx4 v10, s[4:7], s75 offen offset:2048 sc1 lds
  buffer_load_dwordx4 v11, s[4:7], s75 offen offset:3072 sc1 lds
  v_readlane_b32 s59, v28, s58
  s_add_u32 s62, s52, s54
  s_mov_b32 m0, s62
  s_add_u32 s58, s58, 1
  s_add_u32 s52, s52, 32768
  s_and_b32 s52, s52, 131071
  s_lshl_b32 s53, s59, s57
  s_add_u32 s53, s53, s70
  s_add_u32 s55, s59, s71
  s_waitcnt vmcnt(8)
  s_barrier
  buffer_load_dwordx4 v8, s[4:7], s53 offen offset:0 sc1 lds
  buffer_load_dwordx4 v9, s[4:7], s53 offen offset:1024 sc1 lds
  buffer_load_dwordx4 v10, s[4:7], s53 offen offset:2048 sc1 lds
  buffer_load_dwordx4 v11, s[4:7], s53 offen offset:3072 sc1 lds
  s_add_u32 m0, s62, 16384
  s_nop 0
  buffer_load_dwordx4 v12, s[8:11], s55 offen offset:0 lds
  buffer_load_dwordx4 v13, s[8:11], s55 offen offset:1024 lds
  buffer_load_dwordx4 v14, s[8:11], s55 offen offset:2048 lds
  buffer_load_dwordx4 v15, s[8:11], s55 offen offset:3072 lds
  v_readlane_b32 s59, v28, s58
  s_add_u32 s62, s52, s54
  s_mov_b32 m0, s62
  s_add_u32 s58, s58, 1
  s_add_u32 s52, s52, 32768
  s_and_b32 s52, s52, 131071
  s_lshl_b32 s53, s59, s57
  s_add_u32 s53, s53, s70
  s_add_u32 s55, s59, s71
  s_waitcnt vmcnt(12)
  s_barrier
  s_mov_b32 s63, 5
  s_mov_b32 s61, 30
  s_branch L_lloop
L_lend:
  s_waitcnt vmcnt(8)
  s_barrier
  s_waitcnt vmcnt(0)
  s_barrier
L_done:
  s_endpgm
L_compute:
  s_getpc_b64 s[30:31]
L_pc:
  s_sub_u32 s30, s30, L_pc-standalone__spectral_fnet__prompt_kernel
  s_subb_u32 s31, s31, 0
  v_lshlrev_b32 v3, 7, v0
  v_min_u32 v3, L_end-standalone__spectral_fnet__prompt_kernel-4, v3
  v_and_b32 v3, 0xfffffffc, v3
  global_load_dword v31, v3, s[30:31]
  s_and_b32 s50, s20, 1
  s_lshr_b32 s51, s20, 1
  v_and_b32 v3, 15, v2
  v_lshrrev_b32 v4, 4, v2
  v_lshrrev_b32 v5, 1, v3
  v_xor_b32 v5, v5, v4
  v_lshlrev_b32 v5, 4, v5
  v_lshlrev_b32 v6, 7, v3
  v_add_u32 v5, v5, v6
  s_lshl_b32 s52, s50, 13
  v_add_u32 v8, s52, v5
  v_xor_b32 v9, 64, v8
  v_add_u32 v10, 0x10000, v8
  v_add_u32 v11, 0x10000, v9
  s_lshl_b32 s52, s51, 13
  s_add_u32 s52, s52, 16384
  v_add_u32 v12, s52, v5
  v_xor_b32 v13, 64, v12
  v_add_u32 v14, 0x10000, v12
  v_add_u32 v15, 0x10000, v13
  s_lshl_b32 s52, s51, 13
  s_add_u32 s52, s52, 20480
  v_add_u32 v26, s52, v5
  v_xor_b32 v27, 64, v26
  v_add_u32 v28, 0x10000, v26
  v_add_u32 v29, 0x10000, v27
  v_lshlrev_b32 v6, 7, v3
  v_and_b32 v7, 1, v4
  v_lshlrev_b32 v7, 3, v7
  v_add_u32 v6, v6, v7
  v_lshrrev_b32 v7, 1, v3
  v_lshrrev_b32 v30, 5, v2
  v_xor_b32 v7, v7, v30
  v_lshlrev_b32 v7, 4, v7
  s_lshl_b32 s71, s50, 15
  s_lshl_b32 s52, s51, 13
  s_add_u32 s71, s71, s52
  v_add_u32 v6, s71, v6
  v_xor_b32 v30, 0, v7
  v_add_u32 v16, v6, v30
  v_xor_b32 v30, 32, v7
  v_add_u32 v17, v6, v30
  v_xor_b32 v30, 64, v7
  v_add_u32 v18, v6, v30
  v_xor_b32 v30, 96, v7
  v_add_u32 v19, v6, v30
  v_lshrrev_b32 v6, 3, v2
  v_and_b32 v7, 7, v2
  v_xor_b32 v30, v7, v4
  v_lshlrev_b32 v30, 4, v30
  v_lshlrev_b32 v20, 7, v6
  v_add_u32 v20, v20, v30
  v_add_u32 v20, s71, v20
  v_xor_b32 v21, 64, v20
  s_lshl_b32 s54, s3, 3
  s_add_u32 s54, s54, s28
  s_lshl_b32 s54, s54, 5
  s_lshl_b32 s55, s27, 1
  s_add_u32 s54, s54, s55
  s_add_u32 s54, s54, s50
  s_lshl_b32 s54, s54, 1
  s_add_u32 s54, s54, s51
  s_lshl_b32 s54, s54, 13
  v_lshlrev_b32 v25, 4, v2
  v_add_u32 v22, s54, v25
  v_add_u32 v25, s71, v25
  v_lshlrev_b32 v7, 4, v7
  s_lshl_b32 s54, s27, 7
  s_lshl_b32 s55, s51, 6
  s_add_u32 s54, s54, s55
  s_lshl_b32 s55, s3, 5
  s_add_u32 s54, s54, s55
  v_add_u32 v6, s54, v6
  v_lshlrev_b32 v6, 11, v6
  v_add_u32 v6, v6, v7
  s_lshl_b32 s54, s28, 8
  s_lshl_b32 s55, s50, 7
  s_add_u32 s54, s54, s55
  v_add_u32 v23, s54, v6
  s_xor_b32 s52, s2, 1
  s_lshl_b32 s52, s52, 2
  s_add_u32 s52, s52, s20
  s_lshl_b32 s52, s52, 12
  v_lshlrev_b32 v24, 4, v2
  v_add_u32 v24, s52, v24
  s_mul_i32 s70, s3, 0x80008000
  s_lshl_b32 s72, s3, 12
  v_mov_b32 v4, -1
  v_mov_b32 v5, -1
  v_mov_b32 v6, -1
  v_mov_b32 v7, -1
  s_waitcnt lgkmcnt(0)
  s_mov_b32 s56, s42
  s_mov_b32 s57, s43
  s_mov_b32 s58, 0x400000
  s_mov_b32 s59, 0x20000
  s_mov_b32 s12, s46
  s_mov_b32 s13, s47
  s_mov_b32 s14, 0x800000
  s_mov_b32 s15, 0x20000
  s_add_u32 s60, s46, 0x800000
  s_addc_u32 s61, s47, 0
  s_mov_b32 s62, 0x400000
  s_mov_b32 s63, 0x20000
  s_mov_b32 s73, 0
  s_mov_b32 s74, s20
  s_mov_b32 s75, 0
  s_mov_b32 s53, 4
L_pstart:
  v_mov_b32 v160, 0
  v_mov_b32 v161, 0
  v_mov_b32 v162, 0
  v_mov_b32 v163, 0
  v_mov_b32 v164, 0
  v_mov_b32 v165, 0
  v_mov_b32 v166, 0
  v_mov_b32 v167, 0
  v_mov_b32 v168, 0
  v_mov_b32 v169, 0
  v_mov_b32 v170, 0
  v_mov_b32 v171, 0
  v_mov_b32 v172, 0
  v_mov_b32 v173, 0
  v_mov_b32 v174, 0
  v_mov_b32 v175, 0
  v_mov_b32 v176, 0
  v_mov_b32 v177, 0
  v_mov_b32 v178, 0
  v_mov_b32 v179, 0
  v_mov_b32 v180, 0
  v_mov_b32 v181, 0
  v_mov_b32 v182, 0
  v_mov_b32 v183, 0
  v_mov_b32 v184, 0
  v_mov_b32 v185, 0
  v_mov_b32 v186, 0
  v_mov_b32 v187, 0
  v_mov_b32 v188, 0
  v_mov_b32 v189, 0
  v_mov_b32 v190, 0
  v_mov_b32 v191, 0
  v_mov_b32 v192, 0
  v_mov_b32 v193, 0
  v_mov_b32 v194, 0
  v_mov_b32 v195, 0
  v_mov_b32 v196, 0
  v_mov_b32 v197, 0
  v_mov_b32 v198, 0
  v_mov_b32 v199, 0
  v_mov_b32 v200, 0
  v_mov_b32 v201, 0
  v_mov_b32 v202, 0
  v_mov_b32 v203, 0
  v_mov_b32 v204, 0
  v_mov_b32 v205, 0
  v_mov_b32 v206, 0
  v_mov_b32 v207, 0
  v_mov_b32 v208, 0
  v_mov_b32 v209, 0
  v_mov_b32 v210, 0
  v_mov_b32 v211, 0
  v_mov_b32 v212, 0
  v_mov_b32 v213, 0
  v_mov_b32 v214, 0
  v_mov_b32 v215, 0
  v_mov_b32 v216, 0
  v_mov_b32 v217, 0
  v_mov_b32 v218, 0
  v_mov_b32 v219, 0
  v_mov_b32 v220, 0
  v_mov_b32 v221, 0
  v_mov_b32 v222, 0
  v_mov_b32 v223, 0
  s_barrier
  ds_read_b128 v[32:35], v8 offset:0
  ds_read_b128 v[48:51], v12 offset:0
  ds_read_b128 v[52:55], v12 offset:2048
  ds_read_b128 v[56:59], v26 offset:0
  ds_read_b128 v[60:63], v26 offset:2048
  ds_read_b128 v[36:39], v8 offset:2048
  ds_read_b128 v[40:43], v8 offset:4096
  ds_read_b128 v[44:47], v8 offset:6144
  ds_read_b128 v[64:67], v9 offset:0
  ds_read_b128 v[80:83], v13 offset:0
  ds_read_b128 v[84:87], v13 offset:2048
  ds_read_b128 v[88:91], v27 offset:0
  ds_read_b128 v[92:95], v27 offset:2048
  ds_read_b128 v[68:71], v9 offset:2048
  ds_read_b128 v[72:75], v9 offset:4096
  ds_read_b128 v[76:79], v9 offset:6144
.p2align 6
L_u0:
  s_waitcnt lgkmcnt(8)
  v_mfma_f32_16x16x32_bf16 v[160:163], v[32:35], v[48:51], v[160:163]
  v_mfma_f32_16x16x32_bf16 v[164:167], v[32:35], v[52:55], v[164:167]
  v_mfma_f32_16x16x32_bf16 v[168:171], v[32:35], v[56:59], v[168:171]
  v_mfma_f32_16x16x32_bf16 v[172:175], v[32:35], v[60:63], v[172:175]
  v_mfma_f32_16x16x32_bf16 v[188:191], v[36:39], v[60:63], v[188:191]
  v_mfma_f32_16x16x32_bf16 v[184:187], v[36:39], v[56:59], v[184:187]
  v_mfma_f32_16x16x32_bf16 v[180:183], v[36:39], v[52:55], v[180:183]
  v_mfma_f32_16x16x32_bf16 v[176:179], v[36:39], v[48:51], v[176:179]
  v_mfma_f32_16x16x32_bf16 v[192:195], v[40:43], v[48:51], v[192:195]
  v_mfma_f32_16x16x32_bf16 v[196:199], v[40:43], v[52:55], v[196:199]
  v_mfma_f32_16x16x32_bf16 v[200:203], v[40:43], v[56:59], v[200:203]
  v_mfma_f32_16x16x32_bf16 v[204:207], v[40:43], v[60:63], v[204:207]
  v_mfma_f32_16x16x32_bf16 v[220:223], v[44:47], v[60:63], v[220:223]
  v_mfma_f32_16x16x32_bf16 v[216:219], v[44:47], v[56:59], v[216:219]
  v_mfma_f32_16x16x32_bf16 v[212:215], v[44:47], v[52:55], v[212:215]
  v_mfma_f32_16x16x32_bf16 v[208:211], v[44:47], v[48:51], v[208:211]
  s_waitcnt lgkmcnt(0)
  s_barrier
  v_mfma_f32_16x16x32_bf16 v[160:163], v[64:67], v[80:83], v[160:163]
  ds_read_b128 v[96:99], v8 offset:32768
  v_mfma_f32_16x16x32_bf16 v[164:167], v[64:67], v[84:87], v[164:167]
  ds_read_b128 v[112:115], v12 offset:32768
  v_mfma_f32_16x16x32_bf16 v[168:171], v[64:67], v[88:91], v[168:171]
  ds_read_b128 v[116:119], v12 offset:34816
  v_mfma_f32_16x16x32_bf16 v[172:175], v[64:67], v[92:95], v[172:175]
  ds_read_b128 v[120:123], v26 offset:32768
  v_mfma_f32_16x16x32_bf16 v[188:191], v[68:71], v[92:95], v[188:191]
  ds_read_b128 v[124:127], v26 offset:34816
  v_mfma_f32_16x16x32_bf16 v[184:187], v[68:71], v[88:91], v[184:187]
  ds_read_b128 v[100:103], v8 offset:34816
  v_mfma_f32_16x16x32_bf16 v[180:183], v[68:71], v[84:87], v[180:183]
  ds_read_b128 v[104:107], v8 offset:36864
  v_mfma_f32_16x16x32_bf16 v[176:179], v[68:71], v[80:83], v[176:179]
  ds_read_b128 v[108:111], v8 offset:38912
  v_mfma_f32_16x16x32_bf16 v[192:195], v[72:75], v[80:83], v[192:195]
  ds_read_b128 v[128:131], v9 offset:32768
  v_mfma_f32_16x16x32_bf16 v[196:199], v[72:75], v[84:87], v[196:199]
  ds_read_b128 v[144:147], v13 offset:32768
  v_mfma_f32_16x16x32_bf16 v[200:203], v[72:75], v[88:91], v[200:203]
  ds_read_b128 v[148:151], v13 offset:34816
  v_mfma_f32_16x16x32_bf16 v[204:207], v[72:75], v[92:95], v[204:207]
  ds_read_b128 v[152:155], v27 offset:32768
  v_mfma_f32_16x16x32_bf16 v[220:223], v[76:79], v[92:95], v[220:223]
  ds_read_b128 v[156:159], v27 offset:34816
  v_mfma_f32_16x16x32_bf16 v[216:219], v[76:79], v[88:91], v[216:219]
  ds_read_b128 v[132:135], v9 offset:34816
  v_mfma_f32_16x16x32_bf16 v[212:215], v[76:79], v[84:87], v[212:215]
  ds_read_b128 v[136:139], v9 offset:36864
  v_mfma_f32_16x16x32_bf16 v[208:211], v[76:79], v[80:83], v[208:211]
  ds_read_b128 v[140:143], v9 offset:38912
  s_cmp_eq_u32 s74, 0
  s_cbranch_scc0 L_ns0
  buffer_store_dwordx4 v[4:7], v24, s[60:63], s75 offen sc1
  s_add_u32 s75, s75, 1024
L_ns0:
  s_waitcnt lgkmcnt(8)
  v_mfma_f32_16x16x32_bf16 v[160:163], v[96:99], v[112:115], v[160:163]
  v_mfma_f32_16x16x32_bf16 v[164:167], v[96:99], v[116:119], v[164:167]
  v_mfma_f32_16x16x32_bf16 v[168:171], v[96:99], v[120:123], v[168:171]
  v_mfma_f32_16x16x32_bf16 v[172:175], v[96:99], v[124:127], v[172:175]
  v_mfma_f32_16x16x32_bf16 v[188:191], v[100:103], v[124:127], v[188:191]
  v_mfma_f32_16x16x32_bf16 v[184:187], v[100:103], v[120:123], v[184:187]
  v_mfma_f32_16x16x32_bf16 v[180:183], v[100:103], v[116:119], v[180:183]
  v_mfma_f32_16x16x32_bf16 v[176:179], v[100:103], v[112:115], v[176:179]
  v_mfma_f32_16x16x32_bf16 v[192:195], v[104:107], v[112:115], v[192:195]
  v_mfma_f32_16x16x32_bf16 v[196:199], v[104:107], v[116:119], v[196:199]
  v_mfma_f32_16x16x32_bf16 v[200:203], v[104:107], v[120:123], v[200:203]
  v_mfma_f32_16x16x32_bf16 v[204:207], v[104:107], v[124:127], v[204:207]
  v_mfma_f32_16x16x32_bf16 v[220:223], v[108:111], v[124:127], v[220:223]
  v_mfma_f32_16x16x32_bf16 v[216:219], v[108:111], v[120:123], v[216:219]
  v_mfma_f32_16x16x32_bf16 v[212:215], v[108:111], v[116:119], v[212:215]
  v_mfma_f32_16x16x32_bf16 v[208:211], v[108:111], v[112:115], v[208:211]
  s_waitcnt lgkmcnt(0)
  s_cmp_eq_u32 s73, 1
  s_cbranch_scc1 L_bx
L_bxr:
  s_barrier
L_bxr2:
  v_mfma_f32_16x16x32_bf16 v[160:163], v[128:131], v[144:147], v[160:163]
  ds_read_b128 v[32:35], v10 offset:0
  v_mfma_f32_16x16x32_bf16 v[164:167], v[128:131], v[148:151], v[164:167]
  ds_read_b128 v[48:51], v14 offset:0
  v_mfma_f32_16x16x32_bf16 v[168:171], v[128:131], v[152:155], v[168:171]
  ds_read_b128 v[52:55], v14 offset:2048
  v_mfma_f32_16x16x32_bf16 v[172:175], v[128:131], v[156:159], v[172:175]
  ds_read_b128 v[56:59], v28 offset:0
  v_mfma_f32_16x16x32_bf16 v[188:191], v[132:135], v[156:159], v[188:191]
  ds_read_b128 v[60:63], v28 offset:2048
  v_mfma_f32_16x16x32_bf16 v[184:187], v[132:135], v[152:155], v[184:187]
  ds_read_b128 v[36:39], v10 offset:2048
  v_mfma_f32_16x16x32_bf16 v[180:183], v[132:135], v[148:151], v[180:183]
  ds_read_b128 v[40:43], v10 offset:4096
  v_mfma_f32_16x16x32_bf16 v[176:179], v[132:135], v[144:147], v[176:179]
  ds_read_b128 v[44:47], v10 offset:6144
  v_mfma_f32_16x16x32_bf16 v[192:195], v[136:139], v[144:147], v[192:195]
  ds_read_b128 v[64:67], v11 offset:0
  v_mfma_f32_16x16x32_bf16 v[196:199], v[136:139], v[148:151], v[196:199]
  ds_read_b128 v[80:83], v15 offset:0
  v_mfma_f32_16x16x32_bf16 v[200:203], v[136:139], v[152:155], v[200:203]
  ds_read_b128 v[84:87], v15 offset:2048
  v_mfma_f32_16x16x32_bf16 v[204:207], v[136:139], v[156:159], v[204:207]
  ds_read_b128 v[88:91], v29 offset:0
  v_mfma_f32_16x16x32_bf16 v[220:223], v[140:143], v[156:159], v[220:223]
  ds_read_b128 v[92:95], v29 offset:2048
  v_mfma_f32_16x16x32_bf16 v[216:219], v[140:143], v[152:155], v[216:219]
  ds_read_b128 v[68:71], v11 offset:2048
  v_mfma_f32_16x16x32_bf16 v[212:215], v[140:143], v[148:151], v[212:215]
  ds_read_b128 v[72:75], v11 offset:4096
  v_mfma_f32_16x16x32_bf16 v[208:211], v[140:143], v[144:147], v[208:211]
  ds_read_b128 v[76:79], v11 offset:6144
  s_cmp_eq_u32 s74, 1
  s_cbranch_scc0 L_ns1
  buffer_store_dwordx4 v[4:7], v24, s[60:63], s75 offen sc1
  s_add_u32 s75, s75, 1024
L_ns1:
  s_waitcnt lgkmcnt(8)
  v_mfma_f32_16x16x32_bf16 v[160:163], v[32:35], v[48:51], v[160:163]
  v_mfma_f32_16x16x32_bf16 v[164:167], v[32:35], v[52:55], v[164:167]
  v_mfma_f32_16x16x32_bf16 v[168:171], v[32:35], v[56:59], v[168:171]
  v_mfma_f32_16x16x32_bf16 v[172:175], v[32:35], v[60:63], v[172:175]
  v_mfma_f32_16x16x32_bf16 v[188:191], v[36:39], v[60:63], v[188:191]
  v_mfma_f32_16x16x32_bf16 v[184:187], v[36:39], v[56:59], v[184:187]
  v_mfma_f32_16x16x32_bf16 v[180:183], v[36:39], v[52:55], v[180:183]
  v_mfma_f32_16x16x32_bf16 v[176:179], v[36:39], v[48:51], v[176:179]
  v_mfma_f32_16x16x32_bf16 v[192:195], v[40:43], v[48:51], v[192:195]
  v_mfma_f32_16x16x32_bf16 v[196:199], v[40:43], v[52:55], v[196:199]
  v_mfma_f32_16x16x32_bf16 v[200:203], v[40:43], v[56:59], v[200:203]
  v_mfma_f32_16x16x32_bf16 v[204:207], v[40:43], v[60:63], v[204:207]
  v_mfma_f32_16x16x32_bf16 v[220:223], v[44:47], v[60:63], v[220:223]
  v_mfma_f32_16x16x32_bf16 v[216:219], v[44:47], v[56:59], v[216:219]
  v_mfma_f32_16x16x32_bf16 v[212:215], v[44:47], v[52:55], v[212:215]
  v_mfma_f32_16x16x32_bf16 v[208:211], v[44:47], v[48:51], v[208:211]
  s_waitcnt lgkmcnt(0)
  s_barrier
  v_mfma_f32_16x16x32_bf16 v[160:163], v[64:67], v[80:83], v[160:163]
  ds_read_b128 v[96:99], v10 offset:32768
  v_mfma_f32_16x16x32_bf16 v[164:167], v[64:67], v[84:87], v[164:167]
  ds_read_b128 v[112:115], v14 offset:32768
  v_mfma_f32_16x16x32_bf16 v[168:171], v[64:67], v[88:91], v[168:171]
  ds_read_b128 v[116:119], v14 offset:34816
  v_mfma_f32_16x16x32_bf16 v[172:175], v[64:67], v[92:95], v[172:175]
  ds_read_b128 v[120:123], v28 offset:32768
  v_mfma_f32_16x16x32_bf16 v[188:191], v[68:71], v[92:95], v[188:191]
  ds_read_b128 v[124:127], v28 offset:34816
  v_mfma_f32_16x16x32_bf16 v[184:187], v[68:71], v[88:91], v[184:187]
  ds_read_b128 v[100:103], v10 offset:34816
  v_mfma_f32_16x16x32_bf16 v[180:183], v[68:71], v[84:87], v[180:183]
  ds_read_b128 v[104:107], v10 offset:36864
  v_mfma_f32_16x16x32_bf16 v[176:179], v[68:71], v[80:83], v[176:179]
  ds_read_b128 v[108:111], v10 offset:38912
  v_mfma_f32_16x16x32_bf16 v[192:195], v[72:75], v[80:83], v[192:195]
  ds_read_b128 v[128:131], v11 offset:32768
  v_mfma_f32_16x16x32_bf16 v[196:199], v[72:75], v[84:87], v[196:199]
  ds_read_b128 v[144:147], v15 offset:32768
  v_mfma_f32_16x16x32_bf16 v[200:203], v[72:75], v[88:91], v[200:203]
  ds_read_b128 v[148:151], v15 offset:34816
  v_mfma_f32_16x16x32_bf16 v[204:207], v[72:75], v[92:95], v[204:207]
  ds_read_b128 v[152:155], v29 offset:32768
  v_mfma_f32_16x16x32_bf16 v[220:223], v[76:79], v[92:95], v[220:223]
  ds_read_b128 v[156:159], v29 offset:34816
  v_mfma_f32_16x16x32_bf16 v[216:219], v[76:79], v[88:91], v[216:219]
  ds_read_b128 v[132:135], v11 offset:34816
  v_mfma_f32_16x16x32_bf16 v[212:215], v[76:79], v[84:87], v[212:215]
  ds_read_b128 v[136:139], v11 offset:36864
  v_mfma_f32_16x16x32_bf16 v[208:211], v[76:79], v[80:83], v[208:211]
  ds_read_b128 v[140:143], v11 offset:38912
  s_cmp_eq_u32 s74, 2
  s_cbranch_scc0 L_ns2
  buffer_store_dwordx4 v[4:7], v24, s[60:63], s75 offen sc1
  s_add_u32 s75, s75, 1024
L_ns2:
  s_sub_u32 s53, s53, 1
  s_cmp_eq_u32 s53, 0
  s_cbranch_scc1 L_cexit
  s_waitcnt lgkmcnt(8)
  v_mfma_f32_16x16x32_bf16 v[160:163], v[96:99], v[112:115], v[160:163]
  v_mfma_f32_16x16x32_bf16 v[164:167], v[96:99], v[116:119], v[164:167]
  v_mfma_f32_16x16x32_bf16 v[168:171], v[96:99], v[120:123], v[168:171]
  v_mfma_f32_16x16x32_bf16 v[172:175], v[96:99], v[124:127], v[172:175]
  v_mfma_f32_16x16x32_bf16 v[188:191], v[100:103], v[124:127], v[188:191]
  v_mfma_f32_16x16x32_bf16 v[184:187], v[100:103], v[120:123], v[184:187]
  v_mfma_f32_16x16x32_bf16 v[180:183], v[100:103], v[116:119], v[180:183]
  v_mfma_f32_16x16x32_bf16 v[176:179], v[100:103], v[112:115], v[176:179]
  v_mfma_f32_16x16x32_bf16 v[192:195], v[104:107], v[112:115], v[192:195]
  v_mfma_f32_16x16x32_bf16 v[196:199], v[104:107], v[116:119], v[196:199]
  v_mfma_f32_16x16x32_bf16 v[200:203], v[104:107], v[120:123], v[200:203]
  v_mfma_f32_16x16x32_bf16 v[204:207], v[104:107], v[124:127], v[204:207]
  v_mfma_f32_16x16x32_bf16 v[220:223], v[108:111], v[124:127], v[220:223]
  v_mfma_f32_16x16x32_bf16 v[216:219], v[108:111], v[120:123], v[216:219]
  v_mfma_f32_16x16x32_bf16 v[212:215], v[108:111], v[116:119], v[212:215]
  v_mfma_f32_16x16x32_bf16 v[208:211], v[108:111], v[112:115], v[208:211]
  s_waitcnt lgkmcnt(0)
  s_barrier
  v_mfma_f32_16x16x32_bf16 v[160:163], v[128:131], v[144:147], v[160:163]
  ds_read_b128 v[32:35], v8 offset:0
  v_mfma_f32_16x16x32_bf16 v[164:167], v[128:131], v[148:151], v[164:167]
  ds_read_b128 v[48:51], v12 offset:0
  v_mfma_f32_16x16x32_bf16 v[168:171], v[128:131], v[152:155], v[168:171]
  ds_read_b128 v[52:55], v12 offset:2048
  v_mfma_f32_16x16x32_bf16 v[172:175], v[128:131], v[156:159], v[172:175]
  ds_read_b128 v[56:59], v26 offset:0
  v_mfma_f32_16x16x32_bf16 v[188:191], v[132:135], v[156:159], v[188:191]
  ds_read_b128 v[60:63], v26 offset:2048
  v_mfma_f32_16x16x32_bf16 v[184:187], v[132:135], v[152:155], v[184:187]
  ds_read_b128 v[36:39], v8 offset:2048
  v_mfma_f32_16x16x32_bf16 v[180:183], v[132:135], v[148:151], v[180:183]
  ds_read_b128 v[40:43], v8 offset:4096
  v_mfma_f32_16x16x32_bf16 v[176:179], v[132:135], v[144:147], v[176:179]
  ds_read_b128 v[44:47], v8 offset:6144
  v_mfma_f32_16x16x32_bf16 v[192:195], v[136:139], v[144:147], v[192:195]
  ds_read_b128 v[64:67], v9 offset:0
  v_mfma_f32_16x16x32_bf16 v[196:199], v[136:139], v[148:151], v[196:199]
  ds_read_b128 v[80:83], v13 offset:0
  v_mfma_f32_16x16x32_bf16 v[200:203], v[136:139], v[152:155], v[200:203]
  ds_read_b128 v[84:87], v13 offset:2048
  v_mfma_f32_16x16x32_bf16 v[204:207], v[136:139], v[156:159], v[204:207]
  ds_read_b128 v[88:91], v27 offset:0
  v_mfma_f32_16x16x32_bf16 v[220:223], v[140:143], v[156:159], v[220:223]
  ds_read_b128 v[92:95], v27 offset:2048
  v_mfma_f32_16x16x32_bf16 v[216:219], v[140:143], v[152:155], v[216:219]
  ds_read_b128 v[68:71], v9 offset:2048
  v_mfma_f32_16x16x32_bf16 v[212:215], v[140:143], v[148:151], v[212:215]
  ds_read_b128 v[72:75], v9 offset:4096
  v_mfma_f32_16x16x32_bf16 v[208:211], v[140:143], v[144:147], v[208:211]
  ds_read_b128 v[76:79], v9 offset:6144
  s_cmp_eq_u32 s74, 3
  s_cbranch_scc0 L_ns3
  buffer_store_dwordx4 v[4:7], v24, s[60:63], s75 offen sc1
  s_add_u32 s75, s75, 1024
L_ns3:
  s_branch L_u0
L_bx:
  s_waitcnt vmcnt(0)
  s_barrier
  s_mov_b32 s73, 2
  s_branch L_bxr
L_cexit:
  s_waitcnt lgkmcnt(0)
  s_cmp_lg_u32 s73, 0
  s_cbranch_scc1 L_final
  v_mfma_f32_16x16x32_bf16 v[160:163], v[96:99], v[112:115], v[160:163]
  v_mfma_f32_16x16x32_bf16 v[160:163], v[128:131], v[144:147], v[160:163]
  v_mfma_f32_16x16x32_bf16 v[176:179], v[100:103], v[112:115], v[176:179]
  v_mfma_f32_16x16x32_bf16 v[176:179], v[132:135], v[144:147], v[176:179]
  v_mfma_f32_16x16x32_bf16 v[192:195], v[104:107], v[112:115], v[192:195]
  v_mfma_f32_16x16x32_bf16 v[192:195], v[136:139], v[144:147], v[192:195]
  v_mfma_f32_16x16x32_bf16 v[208:211], v[108:111], v[112:115], v[208:211]
  s_nop 3
  v_cvt_pk_bf16_f32 v32, v160, v161
  v_cvt_pk_bf16_f32 v33, v162, v163
  v_mfma_f32_16x16x32_bf16 v[208:211], v[140:143], v[144:147], v[208:211]
  v_xor_b32 v32, s70, v32
  v_xor_b32 v33, s70, v33
  ds_write_b64 v16, v[32:33] offset:0
  v_mfma_f32_16x16x32_bf16 v[164:167], v[96:99], v[116:119], v[164:167]
  v_cvt_pk_bf16_f32 v40, v176, v177
  v_cvt_pk_bf16_f32 v41, v178, v179
  v_mfma_f32_16x16x32_bf16 v[164:167], v[128:131], v[148:151], v[164:167]
  v_xor_b32 v40, s70, v40
  v_xor_b32 v41, s70, v41
  ds_write_b64 v17, v[40:41] offset:0
  v_mfma_f32_16x16x32_bf16 v[180:183], v[100:103], v[116:119], v[180:183]
  v_cvt_pk_bf16_f32 v48, v192, v193
  v_cvt_pk_bf16_f32 v49, v194, v195
  v_mfma_f32_16x16x32_bf16 v[180:183], v[132:135], v[148:151], v[180:183]
  v_xor_b32 v48, s70, v48
  v_xor_b32 v49, s70, v49
  ds_write_b64 v18, v[48:49] offset:0
  v_mfma_f32_16x16x32_bf16 v[196:199], v[104:107], v[116:119], v[196:199]
  v_cvt_pk_bf16_f32 v56, v208, v209
  v_cvt_pk_bf16_f32 v57, v210, v211
  v_mfma_f32_16x16x32_bf16 v[196:199], v[136:139], v[148:151], v[196:199]
  v_xor_b32 v56, s70, v56
  v_xor_b32 v57, s70, v57
  ds_write_b64 v19, v[56:57] offset:0
  v_mfma_f32_16x16x32_bf16 v[212:215], v[108:111], v[116:119], v[212:215]
  v_cvt_pk_bf16_f32 v34, v164, v165
  v_cvt_pk_bf16_f32 v35, v166, v167
  v_mfma_f32_16x16x32_bf16 v[212:215], v[140:143], v[148:151], v[212:215]
  v_xor_b32 v34, s70, v34
  v_xor_b32 v35, s70, v35
  ds_write_b64 v16, v[34:35] offset:2048
  v_mfma_f32_16x16x32_bf16 v[168:171], v[96:99], v[120:123], v[168:171]
  v_cvt_pk_bf16_f32 v42, v180, v181
  v_cvt_pk_bf16_f32 v43, v182, v183
  v_mfma_f32_16x16x32_bf16 v[168:171], v[128:131], v[152:155], v[168:171]
  v_xor_b32 v42, s70, v42
  v_xor_b32 v43, s70, v43
  ds_write_b64 v17, v[42:43] offset:2048
  v_mfma_f32_16x16x32_bf16 v[184:187], v[100:103], v[120:123], v[184:187]
  v_cvt_pk_bf16_f32 v50, v196, v197
  v_cvt_pk_bf16_f32 v51, v198, v199
  v_mfma_f32_16x16x32_bf16 v[184:187], v[132:135], v[152:155], v[184:187]
  v_xor_b32 v50, s70, v50
  v_xor_b32 v51, s70, v51
  ds_write_b64 v18, v[50:51] offset:2048
  v_mfma_f32_16x16x32_bf16 v[200:203], v[104:107], v[120:123], v[200:203]
  v_cvt_pk_bf16_f32 v58, v212, v213
  v_cvt_pk_bf16_f32 v59, v214, v215
  v_mfma_f32_16x16x32_bf16 v[200:203], v[136:139], v[152:155], v[200:203]
  v_xor_b32 v58, s70, v58
  v_xor_b32 v59, s70, v59
  ds_write_b64 v19, v[58:59] offset:2048
  v_mfma_f32_16x16x32_bf16 v[216:219], v[108:111], v[120:123], v[216:219]
  v_cvt_pk_bf16_f32 v36, v168, v169
  v_cvt_pk_bf16_f32 v37, v170, v171
  v_mfma_f32_16x16x32_bf16 v[216:219], v[140:143], v[152:155], v[216:219]
  v_xor_b32 v36, s70, v36
  v_xor_b32 v37, s70, v37
  ds_write_b64 v16, v[36:37] offset:4096
  v_mfma_f32_16x16x32_bf16 v[172:175], v[96:99], v[124:127], v[172:175]
  v_cvt_pk_bf16_f32 v44, v184, v185
  v_cvt_pk_bf16_f32 v45, v186, v187
  v_mfma_f32_16x16x32_bf16 v[172:175], v[128:131], v[156:159], v[172:175]
  v_xor_b32 v44, s70, v44
  v_xor_b32 v45, s70, v45
  ds_write_b64 v17, v[44:45] offset:4096
  v_mfma_f32_16x16x32_bf16 v[188:191], v[100:103], v[124:127], v[188:191]
  v_cvt_pk_bf16_f32 v52, v200, v201
  v_cvt_pk_bf16_f32 v53, v202, v203
  v_mfma_f32_16x16x32_bf16 v[188:191], v[132:135], v[156:159], v[188:191]
  v_xor_b32 v52, s70, v52
  v_xor_b32 v53, s70, v53
  ds_write_b64 v18, v[52:53] offset:4096
  v_mfma_f32_16x16x32_bf16 v[204:207], v[104:107], v[124:127], v[204:207]
  v_cvt_pk_bf16_f32 v60, v216, v217
  v_cvt_pk_bf16_f32 v61, v218, v219
  v_mfma_f32_16x16x32_bf16 v[204:207], v[136:139], v[156:159], v[204:207]
  v_xor_b32 v60, s70, v60
  v_xor_b32 v61, s70, v61
  ds_write_b64 v19, v[60:61] offset:4096
  v_mfma_f32_16x16x32_bf16 v[220:223], v[108:111], v[124:127], v[220:223]
  v_cvt_pk_bf16_f32 v38, v172, v173
  v_cvt_pk_bf16_f32 v39, v174, v175
  v_mfma_f32_16x16x32_bf16 v[220:223], v[140:143], v[156:159], v[220:223]
  v_xor_b32 v38, s70, v38
  v_xor_b32 v39, s70, v39
  ds_write_b64 v16, v[38:39] offset:6144
  s_nop 7
  v_cvt_pk_bf16_f32 v46, v188, v189
  v_cvt_pk_bf16_f32 v47, v190, v191
  v_xor_b32 v46, s70, v46
  v_xor_b32 v47, s70, v47
  ds_write_b64 v17, v[46:47] offset:6144
  v_cvt_pk_bf16_f32 v54, v204, v205
  v_cvt_pk_bf16_f32 v55, v206, v207
  v_xor_b32 v54, s70, v54
  v_xor_b32 v55, s70, v55
  ds_write_b64 v18, v[54:55] offset:6144
  v_cvt_pk_bf16_f32 v62, v220, v221
  v_cvt_pk_bf16_f32 v63, v222, v223
  v_xor_b32 v62, s70, v62
  v_xor_b32 v63, s70, v63
  ds_write_b64 v19, v[62:63] offset:6144
  s_waitcnt lgkmcnt(0)
  ds_read_b128 v[64:67], v25 offset:0
  ds_read_b128 v[68:71], v25 offset:1024
  ds_read_b128 v[72:75], v25 offset:2048
  ds_read_b128 v[76:79], v25 offset:3072
  ds_read_b128 v[80:83], v25 offset:4096
  ds_read_b128 v[84:87], v25 offset:5120
  ds_read_b128 v[88:91], v25 offset:6144
  ds_read_b128 v[92:95], v25 offset:7168
  s_waitcnt lgkmcnt(7)
  s_mov_b32 s55, 0
  buffer_store_dwordx4 v[64:67], v22, s[12:15], s55 offen sc1
  s_waitcnt lgkmcnt(6)
  s_mov_b32 s55, 1024
  buffer_store_dwordx4 v[68:71], v22, s[12:15], s55 offen sc1
  s_waitcnt lgkmcnt(5)
  s_mov_b32 s55, 2048
  buffer_store_dwordx4 v[72:75], v22, s[12:15], s55 offen sc1
  s_waitcnt lgkmcnt(4)
  s_mov_b32 s55, 3072
  buffer_store_dwordx4 v[76:79], v22, s[12:15], s55 offen sc1
  s_waitcnt lgkmcnt(3)
  s_mov_b32 s55, 4096
  buffer_store_dwordx4 v[80:83], v22, s[12:15], s55 offen sc1
  s_waitcnt lgkmcnt(2)
  s_mov_b32 s55, 5120
  buffer_store_dwordx4 v[84:87], v22, s[12:15], s55 offen sc1
  s_waitcnt lgkmcnt(1)
  s_mov_b32 s55, 6144
  buffer_store_dwordx4 v[88:91], v22, s[12:15], s55 offen sc1
  s_waitcnt lgkmcnt(0)
  s_mov_b32 s55, 7168
  buffer_store_dwordx4 v[92:95], v22, s[12:15], s55 offen sc1
  s_cmp_eq_u32 s75, 4096
  s_cbranch_scc1 L_nsx
  buffer_store_dwordx4 v[4:7], v24, s[60:63], s75 offen sc1
L_nsx:
  s_mov_b32 s74, 99
  v_xor_b32 v12, s72, v12
  v_xor_b32 v13, s72, v13
  v_xor_b32 v14, s72, v14
  v_xor_b32 v15, s72, v15
  v_xor_b32 v26, s72, v26
  v_xor_b32 v27, s72, v27
  v_xor_b32 v28, s72, v28
  v_xor_b32 v29, s72, v29
  s_mov_b32 s73, 1
  s_mov_b32 s53, 8
  s_branch L_pstart
L_final:
  v_mfma_f32_16x16x32_bf16 v[168:171], v[96:99], v[120:123], v[168:171]
  v_mfma_f32_16x16x32_bf16 v[168:171], v[128:131], v[152:155], v[168:171]
  v_mfma_f32_16x16x32_bf16 v[172:175], v[96:99], v[124:127], v[172:175]
  v_mfma_f32_16x16x32_bf16 v[172:175], v[128:131], v[156:159], v[172:175]
  v_mfma_f32_16x16x32_bf16 v[184:187], v[100:103], v[120:123], v[184:187]
  v_mfma_f32_16x16x32_bf16 v[184:187], v[132:135], v[152:155], v[184:187]
  v_mfma_f32_16x16x32_bf16 v[188:191], v[100:103], v[124:127], v[188:191]
  s_nop 3
  v_cvt_pk_bf16_f32 v32, v168, v169
  v_cvt_pk_bf16_f32 v33, v170, v171
  v_mfma_f32_16x16x32_bf16 v[188:191], v[132:135], v[156:159], v[188:191]
  v_min_u32 v32, -2, v32
  v_min_u32 v33, -2, v33
  v_mfma_f32_16x16x32_bf16 v[200:203], v[104:107], v[120:123], v[200:203]
  v_cvt_pk_bf16_f32 v34, v172, v173
  v_cvt_pk_bf16_f32 v35, v174, v175
  v_mfma_f32_16x16x32_bf16 v[200:203], v[136:139], v[152:155], v[200:203]
  v_min_u32 v34, -2, v34
  v_min_u32 v35, -2, v35
  buffer_store_dwordx4 v[32:35], v24, s[60:63], 0 offen offset:0 sc1
  v_mfma_f32_16x16x32_bf16 v[204:207], v[104:107], v[124:127], v[204:207]
  v_cvt_pk_bf16_f32 v36, v184, v185
  v_cvt_pk_bf16_f32 v37, v186, v187
  v_mfma_f32_16x16x32_bf16 v[204:207], v[136:139], v[156:159], v[204:207]
  v_min_u32 v36, -2, v36
  v_min_u32 v37, -2, v37
  v_mfma_f32_16x16x32_bf16 v[216:219], v[108:111], v[120:123], v[216:219]
  v_cvt_pk_bf16_f32 v38, v188, v189
  v_cvt_pk_bf16_f32 v39, v190, v191
  v_mfma_f32_16x16x32_bf16 v[216:219], v[140:143], v[152:155], v[216:219]
  v_min_u32 v38, -2, v38
  v_min_u32 v39, -2, v39
  buffer_store_dwordx4 v[36:39], v24, s[60:63], 0 offen offset:1024 sc1
  v_mfma_f32_16x16x32_bf16 v[220:223], v[108:111], v[124:127], v[220:223]
  v_cvt_pk_bf16_f32 v40, v200, v201
  v_cvt_pk_bf16_f32 v41, v202, v203
  v_mfma_f32_16x16x32_bf16 v[220:223], v[140:143], v[156:159], v[220:223]
  v_min_u32 v40, -2, v40
  v_min_u32 v41, -2, v41
  v_mfma_f32_16x16x32_bf16 v[160:163], v[96:99], v[112:115], v[160:163]
  v_cvt_pk_bf16_f32 v42, v204, v205
  v_cvt_pk_bf16_f32 v43, v206, v207
  v_mfma_f32_16x16x32_bf16 v[160:163], v[128:131], v[144:147], v[160:163]
  v_min_u32 v42, -2, v42
  v_min_u32 v43, -2, v43
  buffer_store_dwordx4 v[40:43], v24, s[60:63], 0 offen offset:2048 sc1
  v_mfma_f32_16x16x32_bf16 v[164:167], v[96:99], v[116:119], v[164:167]
  v_cvt_pk_bf16_f32 v44, v216, v217
  v_cvt_pk_bf16_f32 v45, v218, v219
  v_mfma_f32_16x16x32_bf16 v[164:167], v[128:131], v[148:151], v[164:167]
  v_min_u32 v44, -2, v44
  v_min_u32 v45, -2, v45
  v_mfma_f32_16x16x32_bf16 v[176:179], v[100:103], v[112:115], v[176:179]
  v_cvt_pk_bf16_f32 v46, v220, v221
  v_cvt_pk_bf16_f32 v47, v222, v223
  v_mfma_f32_16x16x32_bf16 v[176:179], v[132:135], v[144:147], v[176:179]
  v_min_u32 v46, -2, v46
  v_min_u32 v47, -2, v47
  buffer_store_dwordx4 v[44:47], v24, s[60:63], 0 offen offset:3072 sc1
  v_mfma_f32_16x16x32_bf16 v[180:183], v[100:103], v[116:119], v[180:183]
  v_mfma_f32_16x16x32_bf16 v[180:183], v[132:135], v[148:151], v[180:183]
  v_mfma_f32_16x16x32_bf16 v[192:195], v[104:107], v[112:115], v[192:195]
  v_mfma_f32_16x16x32_bf16 v[192:195], v[136:139], v[144:147], v[192:195]
  v_mfma_f32_16x16x32_bf16 v[196:199], v[104:107], v[116:119], v[196:199]
  v_mfma_f32_16x16x32_bf16 v[196:199], v[136:139], v[148:151], v[196:199]
  v_mfma_f32_16x16x32_bf16 v[208:211], v[108:111], v[112:115], v[208:211]
  v_mfma_f32_16x16x32_bf16 v[208:211], v[140:143], v[144:147], v[208:211]
  v_mfma_f32_16x16x32_bf16 v[212:215], v[108:111], v[116:119], v[212:215]
  v_mfma_f32_16x16x32_bf16 v[212:215], v[140:143], v[148:151], v[212:215]
  v_xor_b32 v4, 0x4000, v24
  s_mov_b32 s54, 0x40000
  buffer_load_dwordx4 v[64:67], v4, s[60:63], 0 offen offset:0 sc1
  buffer_load_dwordx4 v[68:71], v4, s[60:63], 0 offen offset:1024 sc1
  buffer_load_dwordx4 v[72:75], v4, s[60:63], 0 offen offset:2048 sc1
  buffer_load_dwordx4 v[76:79], v4, s[60:63], 0 offen offset:3072 sc1
  s_nop 3
  v_cvt_pk_bf16_f32 v48, v160, v161
  v_cvt_pk_bf16_f32 v49, v162, v163
  v_cvt_pk_bf16_f32 v50, v164, v165
  v_cvt_pk_bf16_f32 v51, v166, v167
  v_cvt_pk_bf16_f32 v52, v176, v177
  v_cvt_pk_bf16_f32 v53, v178, v179
  v_cvt_pk_bf16_f32 v54, v180, v181
  v_cvt_pk_bf16_f32 v55, v182, v183
  v_cvt_pk_bf16_f32 v56, v192, v193
  v_cvt_pk_bf16_f32 v57, v194, v195
  v_cvt_pk_bf16_f32 v58, v196, v197
  v_cvt_pk_bf16_f32 v59, v198, v199
  v_cvt_pk_bf16_f32 v60, v208, v209
  v_cvt_pk_bf16_f32 v61, v210, v211
  v_cvt_pk_bf16_f32 v62, v212, v213
  v_cvt_pk_bf16_f32 v63, v214, v215
  v_lshlrev_b32 v128, 16, v48
  v_and_b32 v129, 0xffff0000, v48
  v_lshlrev_b32 v130, 16, v49
  v_and_b32 v131, 0xffff0000, v49
  v_lshlrev_b32 v132, 16, v50
  v_and_b32 v133, 0xffff0000, v50
  v_lshlrev_b32 v134, 16, v51
  v_and_b32 v135, 0xffff0000, v51
  v_lshlrev_b32 v136, 16, v52
  v_and_b32 v137, 0xffff0000, v52
  v_lshlrev_b32 v138, 16, v53
  v_and_b32 v139, 0xffff0000, v53
  v_lshlrev_b32 v140, 16, v54
  v_and_b32 v141, 0xffff0000, v54
  v_lshlrev_b32 v142, 16, v55
  v_and_b32 v143, 0xffff0000, v55
  v_lshlrev_b32 v144, 16, v56
  v_and_b32 v145, 0xffff0000, v56
  v_lshlrev_b32 v146, 16, v57
  v_and_b32 v147, 0xffff0000, v57
  v_lshlrev_b32 v148, 16, v58
  v_and_b32 v149, 0xffff0000, v58
  v_lshlrev_b32 v150, 16, v59
  v_and_b32 v151, 0xffff0000, v59
  v_lshlrev_b32 v152, 16, v60
  v_and_b32 v153, 0xffff0000, v60
  v_lshlrev_b32 v154, 16, v61
  v_and_b32 v155, 0xffff0000, v61
  v_lshlrev_b32 v156, 16, v62
  v_and_b32 v157, 0xffff0000, v62
  v_lshlrev_b32 v158, 16, v63
  v_and_b32 v159, 0xffff0000, v63
  s_branch L_xchk
L_xpoll:
  buffer_load_dwordx4 v[64:67], v4, s[60:63], 0 offen offset:0 sc1
  buffer_load_dwordx4 v[68:71], v4, s[60:63], 0 offen offset:1024 sc1
  buffer_load_dwordx4 v[72:75], v4, s[60:63], 0 offen offset:2048 sc1
  buffer_load_dwordx4 v[76:79], v4, s[60:63], 0 offen offset:3072 sc1
L_xchk:
  s_waitcnt vmcnt(0)
  v_max3_u32 v5, v64, v65, v66
  v_max3_u32 v5, v5, v67, v68
  v_max3_u32 v5, v5, v69, v70
  v_max3_u32 v5, v5, v71, v72
  v_max3_u32 v5, v5, v73, v74
  v_max3_u32 v5, v5, v75, v76
  v_max3_u32 v5, v5, v77, v78
  v_max_u32 v5, v5, v79
  v_cmp_eq_u32 vcc, -1, v5
  s_sub_u32 s54, s54, 1
  s_cmp_eq_u32 s54, 0
  s_cbranch_scc1 L_xdone
  s_cbranch_vccnz L_xpoll
L_xdone:
  v_lshlrev_b32 v4, 16, v64
  v_and_b32 v5, 0xffff0000, v64
  v_pk_add_f32 v[4:5], v[4:5], v[128:129]
  v_cvt_pk_bf16_f32 v80, v4, v5
  v_lshlrev_b32 v6, 16, v65
  v_and_b32 v7, 0xffff0000, v65
  v_pk_add_f32 v[6:7], v[6:7], v[130:131]
  v_cvt_pk_bf16_f32 v81, v6, v7
  ds_write_b64 v16, v[80:81] offset:0
  v_lshlrev_b32 v4, 16, v66
  v_and_b32 v5, 0xffff0000, v66
  v_pk_add_f32 v[4:5], v[4:5], v[132:133]
  v_cvt_pk_bf16_f32 v82, v4, v5
  v_lshlrev_b32 v6, 16, v67
  v_and_b32 v7, 0xffff0000, v67
  v_pk_add_f32 v[6:7], v[6:7], v[134:135]
  v_cvt_pk_bf16_f32 v83, v6, v7
  ds_write_b64 v16, v[82:83] offset:2048
  v_lshlrev_b32 v4, 16, v68
  v_and_b32 v5, 0xffff0000, v68
  v_pk_add_f32 v[4:5], v[4:5], v[136:137]
  v_cvt_pk_bf16_f32 v84, v4, v5
  v_lshlrev_b32 v6, 16, v69
  v_and_b32 v7, 0xffff0000, v69
  v_pk_add_f32 v[6:7], v[6:7], v[138:139]
  v_cvt_pk_bf16_f32 v85, v6, v7
  ds_write_b64 v17, v[84:85] offset:0
  v_lshlrev_b32 v4, 16, v70
  v_and_b32 v5, 0xffff0000, v70
  v_pk_add_f32 v[4:5], v[4:5], v[140:141]
  v_cvt_pk_bf16_f32 v86, v4, v5
  v_lshlrev_b32 v6, 16, v71
  v_and_b32 v7, 0xffff0000, v71
  v_pk_add_f32 v[6:7], v[6:7], v[142:143]
  v_cvt_pk_bf16_f32 v87, v6, v7
  ds_write_b64 v17, v[86:87] offset:2048
  v_lshlrev_b32 v4, 16, v72
  v_and_b32 v5, 0xffff0000, v72
  v_pk_add_f32 v[4:5], v[4:5], v[144:145]
  v_cvt_pk_bf16_f32 v88, v4, v5
  v_lshlrev_b32 v6, 16, v73
  v_and_b32 v7, 0xffff0000, v73
  v_pk_add_f32 v[6:7], v[6:7], v[146:147]
  v_cvt_pk_bf16_f32 v89, v6, v7
  ds_write_b64 v18, v[88:89] offset:0
  v_lshlrev_b32 v4, 16, v74
  v_and_b32 v5, 0xffff0000, v74
  v_pk_add_f32 v[4:5], v[4:5], v[148:149]
  v_cvt_pk_bf16_f32 v90, v4, v5
  v_lshlrev_b32 v6, 16, v75
  v_and_b32 v7, 0xffff0000, v75
  v_pk_add_f32 v[6:7], v[6:7], v[150:151]
  v_cvt_pk_bf16_f32 v91, v6, v7
  ds_write_b64 v18, v[90:91] offset:2048
  v_lshlrev_b32 v4, 16, v76
  v_and_b32 v5, 0xffff0000, v76
  v_pk_add_f32 v[4:5], v[4:5], v[152:153]
  v_cvt_pk_bf16_f32 v92, v4, v5
  v_lshlrev_b32 v6, 16, v77
  v_and_b32 v7, 0xffff0000, v77
  v_pk_add_f32 v[6:7], v[6:7], v[154:155]
  v_cvt_pk_bf16_f32 v93, v6, v7
  ds_write_b64 v19, v[92:93] offset:0
  v_lshlrev_b32 v4, 16, v78
  v_and_b32 v5, 0xffff0000, v78
  v_pk_add_f32 v[4:5], v[4:5], v[156:157]
  v_cvt_pk_bf16_f32 v94, v4, v5
  v_lshlrev_b32 v6, 16, v79
  v_and_b32 v7, 0xffff0000, v79
  v_pk_add_f32 v[6:7], v[6:7], v[158:159]
  v_cvt_pk_bf16_f32 v95, v6, v7
  ds_write_b64 v19, v[94:95] offset:2048
  s_waitcnt lgkmcnt(0)
  ds_read_b128 v[64:67], v20 offset:0
  ds_read_b128 v[68:71], v21 offset:1024
  ds_read_b128 v[72:75], v20 offset:2048
  ds_read_b128 v[76:79], v21 offset:3072
  s_waitcnt lgkmcnt(3)
  s_mov_b32 s55, 0
  buffer_store_dwordx4 v[64:67], v23, s[56:59], s55 offen sc1
  s_waitcnt lgkmcnt(2)
  s_mov_b32 s55, 16384
  buffer_store_dwordx4 v[68:71], v23, s[56:59], s55 offen sc1
  s_waitcnt lgkmcnt(1)
  s_mov_b32 s55, 32768
  buffer_store_dwordx4 v[72:75], v23, s[56:59], s55 offen sc1
  s_waitcnt lgkmcnt(0)
  s_mov_b32 s55, 49152
  buffer_store_dwordx4 v[76:79], v23, s[56:59], s55 offen sc1
  s_endpgm
L_end:
.section .rodata,"a"
.p2align 6
.amdhsa_kernel standalone__spectral_fnet__prompt_kernel
  .amdhsa_next_free_vgpr 224
  .amdhsa_next_free_sgpr 96
  .amdhsa_accum_offset 224
  .amdhsa_group_segment_fixed_size 0
  .amdhsa_kernarg_size 64
  .amdhsa_user_sgpr_count 2
  .amdhsa_user_sgpr_kernarg_segment_ptr 1
  .amdhsa_system_sgpr_workgroup_id_x 1
  .amdhsa_float_denorm_mode_32 3
.end_amdhsa_kernel
```
